```python
import torch

def _softmax(x, axis=-1):
    return torch.softmax(x, dim=axis)
def _gelu(x):
    return torch.nn.functional.gelu(x, approximate="tanh")
def _silu(x):
    return torch.nn.functional.silu(x)
def _sigmoid(x):
    return torch.sigmoid(x)
def _layernorm(x, axis=-1, eps=1e-5):
    m = x.mean(dim=axis, keepdim=True)
    v = x.var(dim=axis, keepdim=True, unbiased=False)
    return (x - m) / torch.sqrt(v + eps)
def _scatter_add(tgt, idx, src, axis=0):
    return tgt.clone().index_add_(axis, idx, src)
def _segment_sum(src, seg, n):
    out = torch.zeros((n,) + src.shape[1:], dtype=src.dtype)
    return out.index_add_(0, seg, src)
def _pad(x, pw):
    flat = tuple(v for pair in reversed(pw) for v in pair)
    return torch.nn.functional.pad(x, flat)

kernel_name = 'sequential_preLN__gqa_block_cached__dense_activation_gelu__decode'

def setup_inputs():

    _w = (lambda a: (lambda t: t.to(torch.bfloat16) if t.is_floating_point() else t)(torch.as_tensor(a)))
    def _A_setup():
        B, Sq, D = 2, 1, 576
        Hq, Hkv, Sk, Dh = 32, 16, 32768, 128
        assert Hq % Hkv == 0, (Hq, Hkv)
        return {
            "x": _w((lambda *s: torch.randn(*s, dtype=torch.bfloat16) * 0.1)(B, Sq, D)),
            "k_cache": _w((lambda *s: torch.randn(*s, dtype=torch.bfloat16) * 1.6)(B, Hkv, Sk, Dh)),
            "v_cache": _w((lambda *s: torch.randn(*s, dtype=torch.bfloat16) * 1.6)(B, Hkv, Sk, Dh)),
            "wq": _w((lambda *s: torch.randn(*s, dtype=torch.bfloat16) * 1.6)(D, Hq * Dh) * (D ** -0.5)),
            "wo": _w((lambda *s: torch.randn(*s, dtype=torch.bfloat16) * 1.6)(Hq * Dh, D) * ((Hq * Dh) ** -0.5)),
        }
    _A_in = _A_setup()

    def _B_setup():
        B, S, D, F = 2, 1, 576, 4608
        return {
            "x": _w((lambda *s: torch.randn(*s, dtype=torch.bfloat16) * 0.1)(B, S, D)),
            "w1": _w((lambda *s: torch.randn(*s, dtype=torch.bfloat16) * 3.2)(D, F) * (D ** -0.5)),
            "b1": _w((lambda *s: torch.randn(*s, dtype=torch.bfloat16) * 3.2)(F) * 0.01),
            "w2": _w((lambda *s: torch.randn(*s, dtype=torch.bfloat16) * 3.2)(F, D) * (F ** -0.5)),
            "b2": _w((lambda *s: torch.randn(*s, dtype=torch.bfloat16) * 3.2)(D) * 0.01),
        }
    _B_in = _B_setup()

    return {
        "A_x": _A_in["x"],
        "A_k_cache": _A_in["k_cache"],
        "A_v_cache": _A_in["v_cache"],
        "A_wq": _A_in["wq"],
        "A_wo": _A_in["wo"],
        "B_x": _B_in["x"],
        "B_w1": _B_in["w1"],
        "B_b1": _B_in["b1"],
        "B_w2": _B_in["w2"],
        "B_b2": _B_in["b2"],
    }

def reference(A_x, A_k_cache, A_v_cache, A_wq, A_wo, B_x, B_w1, B_b1, B_w2, B_b2):
    def _A_ref(x, k_cache, v_cache, wq, wo):
        B, Sq, D = x.shape
        Hq, Dh = 32, 128
        Hkv = k_cache.shape[1]
        rep = Hq // Hkv
        q = (lambda x, *d: x.permute(*d))((x @ wq).reshape(B, Sq, Hq, Dh), 0, 2, 1, 3)
        k = (lambda x, n, axis: torch.repeat_interleave(x, n, dim=axis))(k_cache, rep, axis=1)
        v = (lambda x, n, axis: torch.repeat_interleave(x, n, dim=axis))(v_cache, rep, axis=1)
        scores = torch.einsum("bhqd,bhkd->bhqk", q, k) * (Dh ** -0.5)
        p = _softmax(scores, axis=-1)
        o = torch.einsum("bhqk,bhkd->bhqd", p, v)
        return (lambda x, *d: x.permute(*d))(o, 0, 2, 1, 3).reshape(B, Sq, Hq * Dh) @ wo

    def _B_ref(x, w1, b1, w2, b2):
        h = torch.einsum("bsd,df->bsf", x, w1) + b1
        h = _gelu(h)
        return torch.einsum("bsf,fd->bsd", h, w2) + b2

    x = A_x
    h = x + _A_ref(_layernorm(x, axis=-1), A_k_cache, A_v_cache, A_wq, A_wo)
    h2 = h + _B_ref(_layernorm(h, axis=-1), B_w1, B_b1, B_w2, B_b2)
    return h2
```

```asm
; @launch grid=(256,1,1) block=(512,1,1) lds=96768
.amdgcn_target "amdgcn-amd-amdhsa--gfx950"
.text
.globl sequential_preLN__gqa_block_cached__dense_activation_gelu__decode_kernel
.p2align 8
.type sequential_preLN__gqa_block_cached__dense_activation_gelu__decode_kernel,@function
sequential_preLN__gqa_block_cached__dense_activation_gelu__decode_kernel:
s_cmp_ge_u32 s2, 256
s_cbranch_scc1 L_exit
s_load_dwordx16 s[32:47], s[0:1], 0
s_load_dwordx8 s[48:55], s[0:1], 64
s_load_dwordx2 s[56:57], s[0:1], 96
v_lshrrev_b32 v1, 6, v0
v_and_b32 v0, 63, v0
s_and_b32 s61, s2, 7
v_readfirstlane_b32 s60, v1
s_lshr_b32 s78, s2, 3
s_and_b32 s63, s78, 15
s_lshr_b32 s64, s78, 4
s_mov_b32 s65, s61
s_lshl_b32 s59, s61, 1
s_add_u32 s59, s59, s64
s_mov_b32 s66, s63
s_lshl_b32 s62, s61, 2
s_add_u32 s62, s62, s78
s_and_b32 s62, s62, 31
s_mov_b32 s70, s62
s_mul_i32 s71, s61, 18
s_add_u32 s71, s71, s62
s_sub_u32 s71, s71, 14
v_lshrrev_b32 v56, 4, v0
v_lshlrev_b32 v56, 4, v56
v_and_b32 v57, 1, v0
s_waitcnt lgkmcnt(0)
s_mov_b32 s12, s56
s_mov_b32 s13, s57
s_mov_b32 s14, 16777216
s_mov_b32 s15, 0x20000
s_cmp_ge_u32 s60, 4
s_cbranch_scc1 L_stream
s_mov_b32 s20, s32
s_mov_b32 s21, s33
s_mov_b32 s22, 2304
s_mov_b32 s23, 0x20000
s_mov_b32 s16, s38
s_mov_b32 s17, s39
s_mov_b32 s18, 4718592
s_mov_b32 s19, 0x20000
v_lshrrev_b32 v1, 5, v0
v_mul_u32_u24 v1, 1152, v1
v_and_b32 v2, 31, v0
v_lshl_add_u32 v50, v2, 2, v1
buffer_load_dword v40, v50, s[20:23], 0 offen offset:0
buffer_load_dword v41, v50, s[20:23], 0 offen offset:128
buffer_load_dword v42, v50, s[20:23], 0 offen offset:256
buffer_load_dword v43, v50, s[20:23], 0 offen offset:384
buffer_load_dword v44, v50, s[20:23], 0 offen offset:512
buffer_load_dword v45, v50, s[20:23], 0 offen offset:640
buffer_load_dword v46, v50, s[20:23], 0 offen offset:768
buffer_load_dword v47, v50, s[20:23], 0 offen offset:896
buffer_load_dword v48, v50, s[20:23], 0 offen offset:1024
v_mov_b32 v1, 0
buffer_load_dword v201, v1, s[12:15], 0 offen sc1
v_lshrrev_b32 v1, 1, v0
v_lshlrev_b32 v2, 4, v57
v_lshl_add_u32 v53, v1, 13, v2
s_mul_i32 s69, s60, 5120
s_add_u32 s69, s69, 23040
s_lshl_b32 s72, s59, 9
s_lshl_b32 s3, s66, 5
s_add_u32 s72, s72, s3
s_lshl_b32 s3, s60, 18
s_add_u32 s72, s72, s3
s_add_u32 m0, s69, 0
s_add_u32 s68, s72, 0
buffer_load_dwordx4 v53, s[16:19], s68 offen nt lds
s_add_u32 m0, s69, 1024
s_add_u32 s68, s72, 1048576
buffer_load_dwordx4 v53, s[16:19], s68 offen nt lds
s_add_u32 m0, s69, 2048
s_add_u32 s68, s72, 2097152
buffer_load_dwordx4 v53, s[16:19], s68 offen nt lds
s_add_u32 m0, s69, 3072
s_add_u32 s68, s72, 3145728
buffer_load_dwordx4 v53, s[16:19], s68 offen nt lds
s_cmp_ge_u32 s60, 2
s_cbranch_scc1 L_h1
s_add_u32 m0, s69, 4096
s_add_u32 s68, s72, 4194304
buffer_load_dwordx4 v53, s[16:19], s68 offen nt lds
L_h1:
v_mov_b32 v1, 0
ds_write_b32 v1, v1 offset:22400
ds_write_b32 v1, v1 offset:22404
ds_write_b32 v1, v1 offset:22408
ds_write_b32 v1, v1 offset:22412
s_waitcnt lgkmcnt(0)
s_barrier
s_mul_i32 s73, s60, 2560
v_add_u32 v51, s73, v50
v_bfe_u32 v1, v0, 2, 2
v_lshlrev_b32 v1, 5, v1
v_lshl_add_u32 v1, v56, 4, v1
v_and_b32 v2, 3, v0
v_lshl_add_u32 v1, v2, 3, v1
v_add_u32 v52, s69, v1
v_mul_u32_u24 v1, 1152, v57
v_add3_u32 v58, v1, v56, s73
s_waitcnt vmcnt(4)
v_lshlrev_b32 v8, 16, v40
v_and_b32 v9, 0xffff0000, v40
v_lshlrev_b32 v10, 16, v41
v_and_b32 v11, 0xffff0000, v41
v_lshlrev_b32 v12, 16, v42
v_and_b32 v13, 0xffff0000, v42
v_lshlrev_b32 v14, 16, v43
v_and_b32 v15, 0xffff0000, v43
v_lshlrev_b32 v16, 16, v44
v_and_b32 v17, 0xffff0000, v44
v_lshlrev_b32 v18, 16, v45
v_and_b32 v19, 0xffff0000, v45
v_lshlrev_b32 v20, 16, v46
v_and_b32 v21, 0xffff0000, v46
v_lshlrev_b32 v22, 16, v47
v_and_b32 v23, 0xffff0000, v47
v_lshlrev_b32 v24, 16, v48
v_and_b32 v25, 0xffff0000, v48
v_add_f32 v26, v8, v9
v_add_f32 v26, v26, v10
v_add_f32 v26, v26, v11
v_add_f32 v26, v26, v12
v_add_f32 v26, v26, v13
v_add_f32 v26, v26, v14
v_add_f32 v26, v26, v15
v_add_f32 v26, v26, v16
v_add_f32 v26, v26, v17
v_add_f32 v26, v26, v18
v_add_f32 v26, v26, v19
v_add_f32 v26, v26, v20
v_add_f32 v26, v26, v21
v_add_f32 v26, v26, v22
v_add_f32 v26, v26, v23
v_add_f32 v26, v26, v24
v_add_f32 v26, v26, v25
s_nop 1
v_add_f32_dpp v26, v26, v26 row_ror:8 row_mask:0xf bank_mask:0xf
s_nop 1
v_add_f32_dpp v26, v26, v26 row_ror:4 row_mask:0xf bank_mask:0xf
s_nop 1
v_add_f32_dpp v26, v26, v26 row_ror:2 row_mask:0xf bank_mask:0xf
s_nop 1
v_add_f32_dpp v26, v26, v26 row_ror:1 row_mask:0xf bank_mask:0xf
v_mov_b32 v27, v26
s_nop 1
v_permlane16_swap_b32 v26, v27
v_add_f32 v26, v26, v27
v_mul_f32 v26, 0x3ae38e39, v26
v_mov_b32 v28, v26
v_sub_f32 v8, v8, v26
v_sub_f32 v9, v9, v26
v_sub_f32 v10, v10, v26
v_sub_f32 v11, v11, v26
v_sub_f32 v12, v12, v26
v_sub_f32 v13, v13, v26
v_sub_f32 v14, v14, v26
v_sub_f32 v15, v15, v26
v_sub_f32 v16, v16, v26
v_sub_f32 v17, v17, v26
v_sub_f32 v18, v18, v26
v_sub_f32 v19, v19, v26
v_sub_f32 v20, v20, v26
v_sub_f32 v21, v21, v26
v_sub_f32 v22, v22, v26
v_sub_f32 v23, v23, v26
v_sub_f32 v24, v24, v26
v_sub_f32 v25, v25, v26
v_mul_f32 v26, v8, v8
v_fmac_f32 v26, v9, v9
v_fmac_f32 v26, v10, v10
v_fmac_f32 v26, v11, v11
v_fmac_f32 v26, v12, v12
v_fmac_f32 v26, v13, v13
v_fmac_f32 v26, v14, v14
v_fmac_f32 v26, v15, v15
v_fmac_f32 v26, v16, v16
v_fmac_f32 v26, v17, v17
v_fmac_f32 v26, v18, v18
v_fmac_f32 v26, v19, v19
v_fmac_f32 v26, v20, v20
v_fmac_f32 v26, v21, v21
v_fmac_f32 v26, v22, v22
v_fmac_f32 v26, v23, v23
v_fmac_f32 v26, v24, v24
v_fmac_f32 v26, v25, v25
s_nop 1
v_add_f32_dpp v26, v26, v26 row_ror:8 row_mask:0xf bank_mask:0xf
s_nop 1
v_add_f32_dpp v26, v26, v26 row_ror:4 row_mask:0xf bank_mask:0xf
s_nop 1
v_add_f32_dpp v26, v26, v26 row_ror:2 row_mask:0xf bank_mask:0xf
s_nop 1
v_add_f32_dpp v26, v26, v26 row_ror:1 row_mask:0xf bank_mask:0xf
v_mov_b32 v27, v26
s_nop 1
v_permlane16_swap_b32 v26, v27
v_add_f32 v26, v26, v27
v_mov_b32 v27, 0x3727c5ac
v_fmac_f32 v27, 0x3ae38e39, v26
v_rsq_f32 v27, v27
s_nop 0
v_mul_f32 v8, v8, v27
v_mul_f32 v9, v9, v27
v_mul_f32 v10, v10, v27
v_mul_f32 v11, v11, v27
v_mul_f32 v12, v12, v27
v_mul_f32 v13, v13, v27
v_mul_f32 v14, v14, v27
v_mul_f32 v15, v15, v27
v_mul_f32 v16, v16, v27
v_mul_f32 v17, v17, v27
v_mul_f32 v18, v18, v27
v_mul_f32 v19, v19, v27
v_mul_f32 v20, v20, v27
v_mul_f32 v21, v21, v27
v_mul_f32 v22, v22, v27
v_mul_f32 v23, v23, v27
v_mul_f32 v24, v24, v27
v_mul_f32 v25, v25, v27
v_cvt_pk_bf16_f32 v40, v8, v9
ds_write_b32 v51, v40 offset:0
v_cvt_pk_bf16_f32 v41, v10, v11
ds_write_b32 v51, v41 offset:128
v_cvt_pk_bf16_f32 v42, v12, v13
ds_write_b32 v51, v42 offset:256
v_cvt_pk_bf16_f32 v43, v14, v15
ds_write_b32 v51, v43 offset:384
v_cvt_pk_bf16_f32 v44, v16, v17
ds_write_b32 v51, v44 offset:512
v_cvt_pk_bf16_f32 v45, v18, v19
ds_write_b32 v51, v45 offset:640
v_cvt_pk_bf16_f32 v46, v20, v21
ds_write_b32 v51, v46 offset:768
v_cvt_pk_bf16_f32 v47, v22, v23
ds_write_b32 v51, v47 offset:896
v_cvt_pk_bf16_f32 v48, v24, v25
ds_write_b32 v51, v48 offset:1024
s_mov_b32 s3, 0x9e3779b1
v_mul_lo_u32 v201, v201, s3
v_add_u32 v201, 0x7f4a7c15, v201
s_lshl_b32 s3, s60, 6
v_add_u32 v1, s3, v58
s_waitcnt vmcnt(0) lgkmcnt(0)
ds_read_b64_tr_b16 v[64:65], v52 offset:0
ds_read_b64_tr_b16 v[66:67], v52 offset:128
ds_read_b64_tr_b16 v[68:69], v52 offset:1024
ds_read_b64_tr_b16 v[70:71], v52 offset:1152
ds_read_b64_tr_b16 v[72:73], v52 offset:2048
ds_read_b64_tr_b16 v[74:75], v52 offset:2176
ds_read_b64_tr_b16 v[76:77], v52 offset:3072
ds_read_b64_tr_b16 v[78:79], v52 offset:3200
ds_read_b128 v[8:11], v1 offset:0
ds_read_b128 v[12:15], v1 offset:256
ds_read_b128 v[16:19], v1 offset:512
ds_read_b128 v[20:23], v1 offset:768
v_mov_b32 v28, 0
v_mov_b32 v29, 0
v_mov_b32 v30, 0
v_mov_b32 v31, 0
s_cmp_ge_u32 s60, 2
s_cbranch_scc1 L_h2
ds_read_b64_tr_b16 v[80:81], v52 offset:4096
ds_read_b64_tr_b16 v[82:83], v52 offset:4224
ds_read_b128 v[24:27], v1 offset:1024
s_waitcnt lgkmcnt(0)
v_mfma_f32_16x16x32_bf16 v[28:31], v[80:83], v[24:27], v[28:31]
L_h2:
s_waitcnt lgkmcnt(0)
v_mfma_f32_16x16x32_bf16 v[28:31], v[64:67], v[8:11], v[28:31]
v_mfma_f32_16x16x32_bf16 v[28:31], v[68:71], v[12:15], v[28:31]
v_mfma_f32_16x16x32_bf16 v[28:31], v[72:75], v[16:19], v[28:31]
v_mfma_f32_16x16x32_bf16 v[28:31], v[76:79], v[20:23], v[28:31]
s_lshl_b32 s3, s60, 7
s_add_u32 s3, s3, 10240
v_lshl_add_u32 v1, v57, 6, v56
v_add_u32 v1, s3, v1
s_nop 4
ds_write_b128 v1, v[28:31]
v_mov_b32 v4, 0
v_mov_b32 v2, 1
s_waitcnt lgkmcnt(0)
ds_add_u32 v4, v2 offset:22400
s_cmp_lg_u32 s60, 0
s_cbranch_scc1 L_h3
s_mov_b32 s67, 0x400000
L_qs:
ds_read_b32 v2, v4 offset:22400
s_waitcnt lgkmcnt(0)
v_cmp_gt_u32 vcc, 0x100, v2
s_sub_u32 s67, s67, 1
s_cbranch_scc1 L_qsd
s_cbranch_vccnz L_qs
L_qsd:
v_and_b32 v2, 15, v0
v_lshlrev_b32 v1, 3, v2
ds_read_b64 v[8:9], v1 offset:10240
ds_read_b64 v[10:11], v1 offset:10368
ds_read_b64 v[12:13], v1 offset:10496
ds_read_b64 v[14:15], v1 offset:10624
v_lshrrev_b32 v3, 3, v2
v_lshlrev_b32 v3, 14, v3
v_and_b32 v2, 7, v2
v_lshl_add_u32 v3, v2, 3, v3
s_lshl_b32 s74, s59, 10
s_add_u32 s74, s74, 4096
s_lshl_b32 s3, s66, 6
s_add_u32 s3, s3, s74
s_waitcnt lgkmcnt(0)
v_add_f32 v8, v8, v10
v_add_f32 v9, v9, v11
v_add_f32 v12, v12, v14
v_add_f32 v13, v13, v15
v_add_f32 v8, v8, v12
v_add_f32 v9, v9, v13
v_cvt_pk_bf16_f32 v8, v8, v9
v_mov_b32 v9, v201
s_mov_b64 exec, 0xffff
buffer_store_dwordx2 v[8:9], v3, s[12:15], s3 offen sc1
s_mov_b64 exec, -1
s_lshl_b32 s74, s78, 10
s_add_u32 s74, s74, 4096
v_lshlrev_b32 v3, 4, v0
s_mov_b32 s67, 0x40000
L_qpoll:
buffer_load_dwordx4 v[12:15], v3, s[12:15], s74 offen sc1
s_waitcnt vmcnt(0)
v_cmp_ne_u32 vcc, v13, v201
v_cmp_ne_u32 s[76:77], v15, v201
s_or_b64 vcc, vcc, s[76:77]
s_sub_u32 s67, s67, 1
s_cbranch_scc1 L_qd
s_cbranch_vccnz L_qpoll
L_qd:
v_mov_b32 v13, v14
v_lshlrev_b32 v3, 3, v0
ds_write_b64 v3, v[12:13] offset:10752
s_waitcnt lgkmcnt(0)
L_h3:
s_barrier
s_cmp_lg_u32 s60, 3
s_cbranch_scc1 L_h4
v_mov_b32 v8, -1
v_mov_b32 v9, -1
v_mov_b32 v10, -1
v_mov_b32 v11, -1
s_lshl_b32 s3, s64, 5
s_lshl_b32 s74, s63, 1
s_add_u32 s3, s3, s74
s_lshl_b32 s3, s3, 3
s_add_u32 s3, s3, s65
s_lshl_b32 s74, s3, 9
s_add_u32 s74, s74, 131072
s_lshl_b32 s75, s3, 3
s_add_u32 s75, s75, 65536
v_lshrrev_b32 v1, 5, v0
v_and_b32 v2, 31, v0
v_lshlrev_b32 v3, 12, v1
v_lshl_add_u32 v3, v2, 4, v3
v_lshlrev_b32 v4, 6, v1
buffer_store_dwordx4 v[8:11], v3, s[12:15], s74 offen sc1
buffer_store_dwordx2 v[8:9], v4, s[12:15], s75 offen sc1
s_cmp_ge_u32 s62, 9
s_cbranch_scc1 L_c1
s_mul_i32 s3, s61, 4608
s_lshl_b32 s74, s70, 8
s_add_u32 s3, s3, s74
s_add_u32 s3, s3, 524288
v_mul_u32_u24 v3, 2304, v1
v_lshl_add_u32 v3, v2, 3, v3
buffer_store_dwordx2 v[8:9], v3, s[12:15], s3 offen sc1
L_c1:
s_cmp_lt_u32 s62, 14
s_cbranch_scc1 L_c2
s_mul_i32 s3, s71, 4608
s_add_u32 s3, s3, 1048576
v_lshlrev_b32 v3, 4, v0
v_lshlrev_b32 v4, 3, v0
s_add_u32 s74, s3, 4096
buffer_store_dwordx4 v[8:11], v3, s[12:15], s3 offen offset:0 sc1
buffer_store_dwordx4 v[8:11], v3, s[12:15], s3 offen offset:1024 sc1
buffer_store_dwordx4 v[8:11], v3, s[12:15], s3 offen offset:2048 sc1
buffer_store_dwordx4 v[8:11], v3, s[12:15], s3 offen offset:3072 sc1
buffer_store_dwordx2 v[8:9], v4, s[12:15], s74 offen sc1
L_c2:
s_lshl_b32 s3, s2, 2
s_add_u32 s3, s3, 53248
s_waitcnt vmcnt(0)
v_mov_b32 v1, 0
s_mov_b64 exec, 1
buffer_store_dword v201, v1, s[12:15], s3 offen sc1
s_mov_b64 exec, -1
L_h4:
s_cmp_ge_u32 s62, 9
s_cbranch_scc1 L_w1
s_mov_b32 s16, s40
s_mov_b32 s17, s41
s_mov_b32 s18, 4718592
s_mov_b32 s19, 0x20000
v_lshrrev_b32 v1, 3, v0
v_mul_u32_u24 v1, 1152, v1
v_and_b32 v2, 7, v0
v_lshl_add_u32 v54, v2, 4, v1
s_mul_i32 s72, s61, 589824
s_lshl_b32 s3, s70, 7
s_add_u32 s72, s72, s3
s_mul_i32 s3, s60, 147456
s_add_u32 s72, s72, s3
s_lshl_b32 s69, s60, 14
s_add_u32 s69, s69, 23040
s_add_u32 m0, s69, 0
s_add_u32 s68, s72, 0
buffer_load_dwordx4 v54, s[16:19], s68 offen nt lds
s_add_u32 m0, s69, 1024
s_add_u32 s68, s72, 9216
buffer_load_dwordx4 v54, s[16:19], s68 offen nt lds
s_add_u32 m0, s69, 2048
s_add_u32 s68, s72, 18432
buffer_load_dwordx4 v54, s[16:19], s68 offen nt lds
s_add_u32 m0, s69, 3072
s_add_u32 s68, s72, 27648
buffer_load_dwordx4 v54, s[16:19], s68 offen nt lds
s_add_u32 m0, s69, 4096
s_add_u32 s68, s72, 36864
buffer_load_dwordx4 v54, s[16:19], s68 offen nt lds
s_add_u32 m0, s69, 5120
s_add_u32 s68, s72, 46080
buffer_load_dwordx4 v54, s[16:19], s68 offen nt lds
s_add_u32 m0, s69, 6144
s_add_u32 s68, s72, 55296
buffer_load_dwordx4 v54, s[16:19], s68 offen nt lds
s_add_u32 m0, s69, 7168
s_add_u32 s68, s72, 64512
buffer_load_dwordx4 v54, s[16:19], s68 offen nt lds
s_add_u32 m0, s69, 8192
s_add_u32 s68, s72, 73728
buffer_load_dwordx4 v54, s[16:19], s68 offen nt lds
s_add_u32 m0, s69, 9216
s_add_u32 s68, s72, 82944
buffer_load_dwordx4 v54, s[16:19], s68 offen nt lds
s_add_u32 m0, s69, 10240
s_add_u32 s68, s72, 92160
buffer_load_dwordx4 v54, s[16:19], s68 offen nt lds
s_add_u32 m0, s69, 11264
s_add_u32 s68, s72, 101376
buffer_load_dwordx4 v54, s[16:19], s68 offen nt lds
s_add_u32 m0, s69, 12288
s_add_u32 s68, s72, 110592
buffer_load_dwordx4 v54, s[16:19], s68 offen nt lds
s_add_u32 m0, s69, 13312
s_add_u32 s68, s72, 119808
buffer_load_dwordx4 v54, s[16:19], s68 offen nt lds
s_add_u32 m0, s69, 14336
s_add_u32 s68, s72, 129024
buffer_load_dwordx4 v54, s[16:19], s68 offen nt lds
s_add_u32 m0, s69, 15360
s_add_u32 s68, s72, 138240
buffer_load_dwordx4 v54, s[16:19], s68 offen nt lds
s_lshl_b32 s3, s60, 5
s_add_u32 s3, s3, 23040
v_lshrrev_b32 v1, 1, v56
v_bfe_u32 v2, v0, 2, 2
v_add_u32 v1, v1, v2
v_mul_u32_u24 v1, 128, v1
v_and_b32 v2, 3, v0
v_lshl_add_u32 v1, v2, 3, v1
v_add_u32 v52, s3, v1
L_w1:
s_cmp_lt_u32 s62, 14
s_cbranch_scc1 L_w2
s_mov_b32 s24, s46
s_mov_b32 s25, s47
s_mov_b32 s26, 9216
s_mov_b32 s27, 0x20000
v_and_b32 v1, 31, v0
v_lshlrev_b32 v1, 1, v1
s_lshl_b32 s3, s71, 6
buffer_load_ushort v200, v1, s[24:27], s3 offen
s_mov_b32 s24, s50
s_mov_b32 s25, s51
s_mov_b32 s26, 1152
s_mov_b32 s27, 0x20000
s_cmp_ge_u32 s71, 72
s_cselect_b32 s3, 72, 0
s_sub_u32 s3, s71, s3
s_lshl_b32 s3, s3, 4
v_lshlrev_b32 v1, 3, v57
buffer_load_dwordx2 v[202:203], v1, s[24:27], s3 offen
s_lshr_b32 s3, s60, 1
s_mul_i32 s3, s3, 18432
s_and_b32 s74, s60, 1
s_lshl_b32 s74, s74, 5
s_add_u32 s3, s3, s74
s_add_u32 s3, s3, 23040
v_lshrrev_b32 v1, 1, v56
v_bfe_u32 v2, v0, 2, 2
v_add_u32 v1, v1, v2
v_mul_u32_u24 v1, 64, v1
v_and_b32 v2, 3, v0
v_lshl_add_u32 v1, v2, 3, v1
v_add_u32 v52, s3, v1
s_mul_i32 s3, s60, 288
s_add_u32 s3, s3, 59904
v_lshrrev_b32 v1, 1, v56
v_bfe_u32 v2, v0, 2, 2
v_add_u32 v1, v1, v2
v_mul_u32_u24 v1, 1152, v1
v_and_b32 v2, 3, v0
v_lshl_add_u32 v1, v2, 3, v1
v_add_u32 v53, s3, v1
s_mul_i32 s3, s60, 288
v_lshl_add_u32 v1, v0, 2, s3
v_mov_b32 v2, 0x3f803f80
ds_write_b32 v1, v2 offset:19968
ds_write_b32 v1, v2 offset:20000
v_and_b32 v1, 15, v0
v_min_u32 v59, 2, v1
L_w2:
s_waitcnt vmcnt(0) lgkmcnt(0)
v_lshlrev_b32 v200, 16, v200
s_cmp_lg_u32 s60, 3
s_cbranch_scc1 L_w3
s_mov_b32 s67, 0x40000
v_mov_b32 v1, 0
L_trig:
s_sleep 16
ds_read_b32 v2, v1 offset:22408
s_waitcnt lgkmcnt(0)
v_cmp_eq_u32 vcc, 0, v2
s_sub_u32 s67, s67, 1
s_cbranch_scc1 L_trd
s_cbranch_vccnz L_trig
L_trd:
s_mov_b32 s67, 0x40000
v_lshlrev_b32 v3, 4, v0
s_mov_b32 s3, 53248
L_cpoll:
buffer_load_dwordx4 v[8:11], v3, s[12:15], s3 offen sc1
s_waitcnt vmcnt(0)
v_xor_b32 v8, v8, v201
v_xor_b32 v9, v9, v201
v_xor_b32 v10, v10, v201
v_xor_b32 v11, v11, v201
v_or3_b32 v8, v8, v9, v10
v_or_b32 v8, v8, v11
v_cmp_ne_u32 vcc, 0, v8
s_sub_u32 s67, s67, 1
s_cbranch_scc1 L_cd
s_cbranch_vccnz L_cpoll
L_cd:
v_mov_b32 v2, 1
ds_write_b32 v1, v2 offset:22404
s_waitcnt lgkmcnt(0)
L_w3:
s_barrier
s_branch L_tail
L_stream:
s_lshl_b32 s3, s78, 23
s_sub_u32 s72, s60, 4
s_lshl_b32 s73, s72, 12
s_mul_i32 s28, s65, 1048576
s_add_u32 s28, s28, s73
s_add_u32 s79, s28, 1048576
s_add_u32 s73, s73, 8388608
s_mov_b32 s96, 571544371
s_mov_b32 s29, 1192464
s_and_b32 s79, s62, 3
s_cselect_b32 s96, 572657971, s96
s_cselect_b32 s29, 4624, s29
s_and_b32 s79, s62, 28
s_lshr_b32 s96, s96, s79
s_lshr_b32 s29, s29, s79
s_and_b32 s96, s96, 15
s_and_b32 s29, s29, 15
s_lshl_b32 s79, s79, 4
s_sub_u32 s29, s79, s29
s_and_b32 s79, s61, 1
s_cselect_b32 s79, 1, -1
s_sub_u32 s96, 66, s96
s_lshl_b32 s96, s96, 1
s_add_u32 s96, s96, s79
s_lshr_b32 s28, s72, 1
s_sub_u32 s96, s96, s28
s_add_u32 s96, s96, 1
s_lshr_b32 s96, s96, 1
s_sub_u32 s96, s96, 3
s_and_b32 s28, s62, 4
s_cselect_b32 s79, s79, 0
s_lshl_b32 s29, s29, 1
s_sub_u32 s29, s29, s79
s_lshl_b32 s28, s29, 13
s_lshl_b32 s29, s72, 12
s_add_u32 s28, s28, s29
s_add_u32 s4, s34, s3
s_addc_u32 s5, s35, 0
s_mov_b32 s6, 0x800000
s_mov_b32 s7, 0x20000
s_add_u32 s8, s36, s3
s_addc_u32 s9, s37, 0
s_mov_b32 s10, s6
s_mov_b32 s11, 0x20000
s_mov_b32 s76, 3
v_lshlrev_b32 v2, 4, v0
v_and_b32 v4, 3, v0
v_lshlrev_b32 v4, 10, v4
v_bfe_u32 v5, v0, 2, 2
v_lshlrev_b32 v5, 8, v5
v_add3_u32 v3, v4, v5, v56
s_mov_b32 s31, 0
s_mov_b32 s30, 0x3e0293ee
s_barrier
buffer_load_dwordx4 v[64:67], v3, s[4:7], s28 offen offset:0 nt
buffer_load_dwordx4 v[68:71], v3, s[4:7], s28 offen offset:64 nt
buffer_load_dwordx4 v[72:75], v3, s[4:7], s28 offen offset:128 nt
buffer_load_dwordx4 v[76:79], v3, s[4:7], s28 offen offset:192 nt
buffer_load_dwordx4 v[80:83], v2, s[8:11], s28 offen offset:0 nt
buffer_load_dwordx4 v[84:87], v2, s[8:11], s28 offen offset:1024 nt
buffer_load_dwordx4 v[88:91], v2, s[8:11], s28 offen offset:2048 nt
buffer_load_dwordx4 v[92:95], v2, s[8:11], s28 offen offset:3072 nt
s_add_u32 s28, s28, 16384
buffer_load_dwordx4 v[96:99], v3, s[4:7], s28 offen offset:0 nt
buffer_load_dwordx4 v[100:103], v3, s[4:7], s28 offen offset:64 nt
buffer_load_dwordx4 v[104:107], v3, s[4:7], s28 offen offset:128 nt
buffer_load_dwordx4 v[108:111], v3, s[4:7], s28 offen offset:192 nt
buffer_load_dwordx4 v[112:115], v2, s[8:11], s28 offen offset:0 nt
buffer_load_dwordx4 v[116:119], v2, s[8:11], s28 offen offset:1024 nt
buffer_load_dwordx4 v[120:123], v2, s[8:11], s28 offen offset:2048 nt
buffer_load_dwordx4 v[124:127], v2, s[8:11], s28 offen offset:3072 nt
s_add_u32 s28, s28, 16384
buffer_load_dwordx4 v[128:131], v3, s[4:7], s28 offen offset:0 nt
buffer_load_dwordx4 v[132:135], v3, s[4:7], s28 offen offset:64 nt
buffer_load_dwordx4 v[136:139], v3, s[4:7], s28 offen offset:128 nt
buffer_load_dwordx4 v[140:143], v3, s[4:7], s28 offen offset:192 nt
buffer_load_dwordx4 v[144:147], v2, s[8:11], s28 offen offset:0 nt
buffer_load_dwordx4 v[148:151], v2, s[8:11], s28 offen offset:1024 nt
buffer_load_dwordx4 v[152:155], v2, s[8:11], s28 offen offset:2048 nt
buffer_load_dwordx4 v[156:159], v2, s[8:11], s28 offen offset:3072 nt
s_add_u32 s28, s28, 16384
s_mov_b32 s77, s28
v_cmp_eq_u32 vcc, 1, v57
v_mov_b32 v9, 0xffff
v_mov_b32 v10, 0xffff0000
v_cndmask_b32 v9, v9, v10, vcc
v_bfe_u32 v8, v0, 1, 2
v_cmp_eq_u32 vcc, 0, v8
s_nop 1
v_cndmask_b32 v4, 0, v9, vcc
v_cmp_eq_u32 vcc, 1, v8
s_nop 1
v_cndmask_b32 v5, 0, v9, vcc
v_cmp_eq_u32 vcc, 2, v8
s_nop 1
v_cndmask_b32 v6, 0, v9, vcc
v_cmp_eq_u32 vcc, 3, v8
s_nop 1
v_cndmask_b32 v7, 0, v9, vcc
v_mov_b32 v24, 0xff7fffff
v_mov_b32 v25, 0
v_mov_b32 v28, 0
v_mov_b32 v29, 0
v_mov_b32 v30, 0
v_mov_b32 v31, 0
v_bfe_u32 v1, v0, 3, 1
v_lshl_add_u32 v1, v1, 8, v56
s_barrier
ds_read_b128 v[8:11], v1 offset:10752
ds_read_b128 v[12:15], v1 offset:10816
ds_read_b128 v[16:19], v1 offset:10880
ds_read_b128 v[20:23], v1 offset:10944
s_waitcnt lgkmcnt(0)
L_loop:
s_cmp_eq_u32 s31, 21
s_cbranch_scc1 L_tset
L_tsetd:
s_waitcnt vmcnt(20)
v_mfma_f32_16x16x32_bf16 v[32:35], v[64:67], v[8:11], 0
v_mfma_f32_16x16x32_bf16 v[32:35], v[68:71], v[12:15], v[32:35]
v_mfma_f32_16x16x32_bf16 v[32:35], v[72:75], v[16:19], v[32:35]
v_mfma_f32_16x16x32_bf16 v[32:35], v[76:79], v[20:23], v[32:35]
s_mov_b32 s28, s77
s_add_u32 s77, s77, 16384
s_cmp_lt_u32 s31, s96
s_cselect_b32 s28, s28, 0x800000
s_add_u32 s31, s31, 1
s_cmp_lt_u32 s28, 0x800000
s_cselect_b32 s6, 0x800000, 0
s_cselect_b32 s10, 0x800000, 0
s_addc_u32 s76, s76, 0
buffer_load_dwordx4 v[64:67], v3, s[4:7], s28 offen offset:0 nt
buffer_load_dwordx4 v[68:71], v3, s[4:7], s28 offen offset:64 nt
buffer_load_dwordx4 v[72:75], v3, s[4:7], s28 offen offset:128 nt
buffer_load_dwordx4 v[76:79], v3, s[4:7], s28 offen offset:192 nt
s_nop 4
v_max3_f32 v26, v32, v33, v34
v_max_f32 v26, v26, v35
v_mov_b32 v27, v26
s_nop 1
v_permlane32_swap_b32 v26, v27
v_max_f32 v26, v26, v27
v_mov_b32 v27, v26
s_nop 1
v_permlane16_swap_b32 v26, v27
v_max3_f32 v26, v26, v27, v24
v_sub_f32 v27, v24, v26
v_mul_f32 v27, s30, v27
v_exp_f32 v27, v27
v_mov_b32 v24, v26
v_mul_f32 v26, s30, v26
v_fma_f32 v32, v32, s30, -v26
v_fma_f32 v33, v33, s30, -v26
v_fma_f32 v34, v34, s30, -v26
v_fma_f32 v35, v35, s30, -v26
v_exp_f32 v32, v32
v_exp_f32 v33, v33
v_exp_f32 v34, v34
v_exp_f32 v35, v35
v_mul_f32 v25, v25, v27
v_mul_f32 v28, v28, v27
v_mul_f32 v29, v29, v27
v_mul_f32 v30, v30, v27
v_mul_f32 v31, v31, v27
v_add_f32 v25, v25, v32
v_add_f32 v25, v25, v33
v_add_f32 v25, v25, v34
v_add_f32 v25, v25, v35
v_cvt_pk_bf16_f32 v32, v32, v32
v_cvt_pk_bf16_f32 v33, v33, v33
v_cvt_pk_bf16_f32 v34, v34, v34
v_cvt_pk_bf16_f32 v35, v35, v35
s_waitcnt vmcnt(20)
v_and_b32 v36, v32, v4
v_and_b32 v37, v32, v5
v_and_b32 v38, v32, v6
v_and_b32 v39, v32, v7
s_nop 1
v_mfma_f32_16x16x32_bf16 v[28:31], v[80:83], v[36:39], v[28:31]
v_and_b32 v36, v33, v4
v_and_b32 v37, v33, v5
v_and_b32 v38, v33, v6
v_and_b32 v39, v33, v7
s_nop 1
v_mfma_f32_16x16x32_bf16 v[28:31], v[84:87], v[36:39], v[28:31]
v_and_b32 v36, v34, v4
v_and_b32 v37, v34, v5
v_and_b32 v38, v34, v6
v_and_b32 v39, v34, v7
s_nop 1
v_mfma_f32_16x16x32_bf16 v[28:31], v[88:91], v[36:39], v[28:31]
v_and_b32 v36, v35, v4
v_and_b32 v37, v35, v5
v_and_b32 v38, v35, v6
v_and_b32 v39, v35, v7
s_nop 1
v_mfma_f32_16x16x32_bf16 v[28:31], v[92:95], v[36:39], v[28:31]
buffer_load_dwordx4 v[80:83], v2, s[8:11], s28 offen offset:0 nt
buffer_load_dwordx4 v[84:87], v2, s[8:11], s28 offen offset:1024 nt
buffer_load_dwordx4 v[88:91], v2, s[8:11], s28 offen offset:2048 nt
buffer_load_dwordx4 v[92:95], v2, s[8:11], s28 offen offset:3072 nt
s_cmp_ge_u32 s31, s76
s_cbranch_scc1 L_done
s_waitcnt vmcnt(20)
v_mfma_f32_16x16x32_bf16 v[32:35], v[96:99], v[8:11], 0
v_mfma_f32_16x16x32_bf16 v[32:35], v[100:103], v[12:15], v[32:35]
v_mfma_f32_16x16x32_bf16 v[32:35], v[104:107], v[16:19], v[32:35]
v_mfma_f32_16x16x32_bf16 v[32:35], v[108:111], v[20:23], v[32:35]
s_mov_b32 s28, s77
s_add_u32 s77, s77, 16384
s_cmp_lt_u32 s31, s96
s_cselect_b32 s28, s28, 0x800000
s_add_u32 s31, s31, 1
s_cmp_lt_u32 s28, 0x800000
s_cselect_b32 s6, 0x800000, 0
s_cselect_b32 s10, 0x800000, 0
s_addc_u32 s76, s76, 0
buffer_load_dwordx4 v[96:99], v3, s[4:7], s28 offen offset:0 nt
buffer_load_dwordx4 v[100:103], v3, s[4:7], s28 offen offset:64 nt
buffer_load_dwordx4 v[104:107], v3, s[4:7], s28 offen offset:128 nt
buffer_load_dwordx4 v[108:111], v3, s[4:7], s28 offen offset:192 nt
s_nop 4
v_max3_f32 v26, v32, v33, v34
v_max_f32 v26, v26, v35
v_mov_b32 v27, v26
s_nop 1
v_permlane32_swap_b32 v26, v27
v_max_f32 v26, v26, v27
v_mov_b32 v27, v26
s_nop 1
v_permlane16_swap_b32 v26, v27
v_max3_f32 v26, v26, v27, v24
v_sub_f32 v27, v24, v26
v_mul_f32 v27, s30, v27
v_exp_f32 v27, v27
v_mov_b32 v24, v26
v_mul_f32 v26, s30, v26
v_fma_f32 v32, v32, s30, -v26
v_fma_f32 v33, v33, s30, -v26
v_fma_f32 v34, v34, s30, -v26
v_fma_f32 v35, v35, s30, -v26
v_exp_f32 v32, v32
v_exp_f32 v33, v33
v_exp_f32 v34, v34
v_exp_f32 v35, v35
v_mul_f32 v25, v25, v27
v_mul_f32 v28, v28, v27
v_mul_f32 v29, v29, v27
v_mul_f32 v30, v30, v27
v_mul_f32 v31, v31, v27
v_add_f32 v25, v25, v32
v_add_f32 v25, v25, v33
v_add_f32 v25, v25, v34
v_add_f32 v25, v25, v35
v_cvt_pk_bf16_f32 v32, v32, v32
v_cvt_pk_bf16_f32 v33, v33, v33
v_cvt_pk_bf16_f32 v34, v34, v34
v_cvt_pk_bf16_f32 v35, v35, v35
s_waitcnt vmcnt(20)
v_and_b32 v36, v32, v4
v_and_b32 v37, v32, v5
v_and_b32 v38, v32, v6
v_and_b32 v39, v32, v7
s_nop 1
v_mfma_f32_16x16x32_bf16 v[28:31], v[112:115], v[36:39], v[28:31]
v_and_b32 v36, v33, v4
v_and_b32 v37, v33, v5
v_and_b32 v38, v33, v6
v_and_b32 v39, v33, v7
s_nop 1
v_mfma_f32_16x16x32_bf16 v[28:31], v[116:119], v[36:39], v[28:31]
v_and_b32 v36, v34, v4
v_and_b32 v37, v34, v5
v_and_b32 v38, v34, v6
v_and_b32 v39, v34, v7
s_nop 1
v_mfma_f32_16x16x32_bf16 v[28:31], v[120:123], v[36:39], v[28:31]
v_and_b32 v36, v35, v4
v_and_b32 v37, v35, v5
v_and_b32 v38, v35, v6
v_and_b32 v39, v35, v7
s_nop 1
v_mfma_f32_16x16x32_bf16 v[28:31], v[124:127], v[36:39], v[28:31]
buffer_load_dwordx4 v[112:115], v2, s[8:11], s28 offen offset:0 nt
buffer_load_dwordx4 v[116:119], v2, s[8:11], s28 offen offset:1024 nt
buffer_load_dwordx4 v[120:123], v2, s[8:11], s28 offen offset:2048 nt
buffer_load_dwordx4 v[124:127], v2, s[8:11], s28 offen offset:3072 nt
s_cmp_ge_u32 s31, s76
s_cbranch_scc1 L_done
s_cmp_eq_u32 s31, 56
s_cbranch_scc1 L_gate
L_gated:
s_waitcnt vmcnt(20)
v_mfma_f32_16x16x32_bf16 v[32:35], v[128:131], v[8:11], 0
v_mfma_f32_16x16x32_bf16 v[32:35], v[132:135], v[12:15], v[32:35]
v_mfma_f32_16x16x32_bf16 v[32:35], v[136:139], v[16:19], v[32:35]
v_mfma_f32_16x16x32_bf16 v[32:35], v[140:143], v[20:23], v[32:35]
s_mov_b32 s28, s77
s_add_u32 s77, s77, 16384
s_cmp_lt_u32 s31, s96
s_cselect_b32 s28, s28, 0x800000
s_add_u32 s31, s31, 1
s_cmp_lt_u32 s28, 0x800000
s_cselect_b32 s6, 0x800000, 0
s_cselect_b32 s10, 0x800000, 0
s_addc_u32 s76, s76, 0
buffer_load_dwordx4 v[128:131], v3, s[4:7], s28 offen offset:0 nt
buffer_load_dwordx4 v[132:135], v3, s[4:7], s28 offen offset:64 nt
buffer_load_dwordx4 v[136:139], v3, s[4:7], s28 offen offset:128 nt
buffer_load_dwordx4 v[140:143], v3, s[4:7], s28 offen offset:192 nt
s_nop 4
v_max3_f32 v26, v32, v33, v34
v_max_f32 v26, v26, v35
v_mov_b32 v27, v26
s_nop 1
v_permlane32_swap_b32 v26, v27
v_max_f32 v26, v26, v27
v_mov_b32 v27, v26
s_nop 1
v_permlane16_swap_b32 v26, v27
v_max3_f32 v26, v26, v27, v24
v_sub_f32 v27, v24, v26
v_mul_f32 v27, s30, v27
v_exp_f32 v27, v27
v_mov_b32 v24, v26
v_mul_f32 v26, s30, v26
v_fma_f32 v32, v32, s30, -v26
v_fma_f32 v33, v33, s30, -v26
v_fma_f32 v34, v34, s30, -v26
v_fma_f32 v35, v35, s30, -v26
v_exp_f32 v32, v32
v_exp_f32 v33, v33
v_exp_f32 v34, v34
v_exp_f32 v35, v35
v_mul_f32 v25, v25, v27
v_mul_f32 v28, v28, v27
v_mul_f32 v29, v29, v27
v_mul_f32 v30, v30, v27
v_mul_f32 v31, v31, v27
v_add_f32 v25, v25, v32
v_add_f32 v25, v25, v33
v_add_f32 v25, v25, v34
v_add_f32 v25, v25, v35
v_cvt_pk_bf16_f32 v32, v32, v32
v_cvt_pk_bf16_f32 v33, v33, v33
v_cvt_pk_bf16_f32 v34, v34, v34
v_cvt_pk_bf16_f32 v35, v35, v35
s_waitcnt vmcnt(20)
v_and_b32 v36, v32, v4
v_and_b32 v37, v32, v5
v_and_b32 v38, v32, v6
v_and_b32 v39, v32, v7
s_nop 1
v_mfma_f32_16x16x32_bf16 v[28:31], v[144:147], v[36:39], v[28:31]
v_and_b32 v36, v33, v4
v_and_b32 v37, v33, v5
v_and_b32 v38, v33, v6
v_and_b32 v39, v33, v7
s_nop 1
v_mfma_f32_16x16x32_bf16 v[28:31], v[148:151], v[36:39], v[28:31]
v_and_b32 v36, v34, v4
v_and_b32 v37, v34, v5
v_and_b32 v38, v34, v6
v_and_b32 v39, v34, v7
s_nop 1
v_mfma_f32_16x16x32_bf16 v[28:31], v[152:155], v[36:39], v[28:31]
v_and_b32 v36, v35, v4
v_and_b32 v37, v35, v5
v_and_b32 v38, v35, v6
v_and_b32 v39, v35, v7
s_nop 1
v_mfma_f32_16x16x32_bf16 v[28:31], v[156:159], v[36:39], v[28:31]
buffer_load_dwordx4 v[144:147], v2, s[8:11], s28 offen offset:0 nt
buffer_load_dwordx4 v[148:151], v2, s[8:11], s28 offen offset:1024 nt
buffer_load_dwordx4 v[152:155], v2, s[8:11], s28 offen offset:2048 nt
buffer_load_dwordx4 v[156:159], v2, s[8:11], s28 offen offset:3072 nt
s_cmp_ge_u32 s31, s76
s_cbranch_scc1 L_done
s_branch L_loop
L_gate:
s_mov_b32 s67, 0x400000
v_mov_b32 v1, 0
L_g1:
ds_read_b32 v26, v1 offset:22404
s_waitcnt lgkmcnt(0)
v_cmp_eq_u32 vcc, 0, v26
s_sub_u32 s67, s67, 1
s_cbranch_scc1 L_g2
s_cbranch_vccnz L_g1
L_g2:
s_branch L_gated
L_tset:
v_mov_b32 v1, 0
v_mov_b32 v26, 1
ds_write_b32 v1, v26 offset:22408
s_branch L_tsetd
L_done:
v_mov_b32 v27, v25
s_nop 1
v_permlane32_swap_b32 v25, v27
v_add_f32 v25, v25, v27
v_mov_b32 v27, v25
s_nop 1
v_permlane16_swap_b32 v25, v27
v_add_f32 v25, v25, v27
v_mul_f32 v24, s30, v24
v_bfe_u32 v1, v0, 3, 1
v_and_b32 v2, 7, v0
v_lshlrev_b32 v3, 9, v1
v_lshl_add_u32 v3, v56, 3, v3
v_lshl_add_u32 v3, v2, 2, v3
s_lshl_b32 s3, s72, 10
v_add_u32 v3, s3, v3
s_lshl_b32 s3, s72, 4
v_lshl_add_u32 v1, v1, 3, s3
ds_write_b32 v3, v28 offset:11264
ds_write_b32 v3, v29 offset:11296
ds_write_b32 v3, v30 offset:11328
ds_write_b32 v3, v31 offset:11360
ds_write_b64 v1, v[24:25] offset:15360
s_waitcnt lgkmcnt(0)
s_barrier
s_cmp_lg_u32 s60, 4
s_cbranch_scc1 L_tail
v_lshlrev_b32 v3, 4, v0
v_lshrrev_b32 v1, 5, v0
v_lshlrev_b32 v4, 3, v1
ds_read_b64 v[24:25], v4 offset:15360
ds_read_b64 v[26:27], v4 offset:15376
ds_read_b64 v[28:29], v4 offset:15392
ds_read_b64 v[30:31], v4 offset:15408
ds_read_b128 v[8:11], v3 offset:11264
ds_read_b128 v[12:15], v3 offset:12288
ds_read_b128 v[16:19], v3 offset:13312
ds_read_b128 v[20:23], v3 offset:14336
s_lshl_b32 s3, s64, 5
s_lshl_b32 s74, s63, 1
s_add_u32 s3, s3, s74
s_lshl_b32 s3, s3, 3
s_add_u32 s3, s3, s65
s_lshl_b32 s74, s3, 9
s_add_u32 s74, s74, 131072
s_lshl_b32 s75, s3, 3
s_add_u32 s75, s75, 65536
v_and_b32 v2, 31, v0
v_lshlrev_b32 v3, 12, v1
v_lshl_add_u32 v3, v2, 4, v3
v_lshlrev_b32 v4, 6, v1
s_waitcnt lgkmcnt(4)
v_max3_f32 v32, v24, v26, v28
v_max_f32 v32, v32, v30
v_sub_f32 v24, v24, v32
v_sub_f32 v26, v26, v32
v_sub_f32 v28, v28, v32
v_sub_f32 v30, v30, v32
v_exp_f32 v24, v24
v_exp_f32 v26, v26
v_exp_f32 v28, v28
v_exp_f32 v30, v30
s_nop 0
v_mul_f32 v33, v24, v25
v_fmac_f32 v33, v26, v27
v_fmac_f32 v33, v28, v29
v_fmac_f32 v33, v30, v31
s_waitcnt lgkmcnt(0)
v_mul_f32 v8, v8, v24
v_mul_f32 v9, v9, v24
v_mul_f32 v10, v10, v24
v_mul_f32 v11, v11, v24
v_fmac_f32 v8, v12, v26
v_fmac_f32 v9, v13, v26
v_fmac_f32 v10, v14, v26
v_fmac_f32 v11, v15, v26
v_fmac_f32 v8, v16, v28
v_fmac_f32 v9, v17, v28
v_fmac_f32 v10, v18, v28
v_fmac_f32 v11, v19, v28
v_fmac_f32 v8, v20, v30
v_fmac_f32 v9, v21, v30
v_fmac_f32 v10, v22, v30
v_fmac_f32 v11, v23, v30
v_min_u32 v8, -2, v8
v_min_u32 v9, -2, v9
v_min_u32 v10, -2, v10
v_min_u32 v11, -2, v11
v_min_u32 v32, -2, v32
v_min_u32 v33, -2, v33
buffer_store_dwordx4 v[8:11], v3, s[12:15], s74 offen sc1
s_mov_b32 exec_lo, 1
s_mov_b32 exec_hi, 1
buffer_store_dwordx2 v[32:33], v4, s[12:15], s75 offen sc1
s_mov_b64 exec, -1
L_tail:
s_cmp_ge_u32 s62, 14
s_cbranch_scc1 L_mlp
s_cmp_lt_u32 s62, 9
s_cbranch_scc1 L_att
s_endpgm
L_att:
s_lshr_b32 s3, s60, 2
s_lshl_b32 s3, s3, 5
s_lshl_b32 s74, s61, 2
s_add_u32 s3, s3, s74
s_and_b32 s74, s60, 3
s_add_u32 s3, s3, s74
s_lshl_b32 s74, s3, 12
s_add_u32 s74, s74, 131072
s_lshl_b32 s75, s3, 6
s_add_u32 s75, s75, 65536
v_lshlrev_b32 v3, 4, v0
v_lshrrev_b32 v1, 5, v0
v_xor_b32 v4, v0, v1
v_and_b32 v4, 7, v4
v_lshlrev_b32 v4, 3, v4
s_mov_b32 s67, 0x40000
buffer_load_dwordx2 v[24:25], v4, s[12:15], s75 offen sc1
buffer_load_dwordx4 v[8:11], v3, s[12:15], s74 offen offset:0 sc1
buffer_load_dwordx4 v[12:15], v3, s[12:15], s74 offen offset:1024 sc1
buffer_load_dwordx4 v[16:19], v3, s[12:15], s74 offen offset:2048 sc1
buffer_load_dwordx4 v[20:23], v3, s[12:15], s74 offen offset:3072 sc1
s_cmp_ge_u32 s60, 4
s_cbranch_scc1 L_sh4
ds_read_b64_tr_b16 v[64:65], v52 offset:0
ds_read_b64_tr_b16 v[66:67], v52 offset:512
ds_read_b64_tr_b16 v[68:69], v52 offset:4096
ds_read_b64_tr_b16 v[70:71], v52 offset:4608
ds_read_b64_tr_b16 v[72:73], v52 offset:8192
ds_read_b64_tr_b16 v[74:75], v52 offset:8704
ds_read_b64_tr_b16 v[76:77], v52 offset:12288
ds_read_b64_tr_b16 v[78:79], v52 offset:12800
ds_read_b64_tr_b16 v[80:81], v52 offset:16384
ds_read_b64_tr_b16 v[82:83], v52 offset:16896
ds_read_b64_tr_b16 v[84:85], v52 offset:20480
ds_read_b64_tr_b16 v[86:87], v52 offset:20992
ds_read_b64_tr_b16 v[88:89], v52 offset:24576
ds_read_b64_tr_b16 v[90:91], v52 offset:25088
ds_read_b64_tr_b16 v[92:93], v52 offset:28672
ds_read_b64_tr_b16 v[94:95], v52 offset:29184
ds_read_b64_tr_b16 v[96:97], v52 offset:32768
ds_read_b64_tr_b16 v[98:99], v52 offset:33280
ds_read_b64_tr_b16 v[100:101], v52 offset:36864
ds_read_b64_tr_b16 v[102:103], v52 offset:37376
ds_read_b64_tr_b16 v[104:105], v52 offset:40960
ds_read_b64_tr_b16 v[106:107], v52 offset:41472
ds_read_b64_tr_b16 v[108:109], v52 offset:45056
ds_read_b64_tr_b16 v[110:111], v52 offset:45568
ds_read_b64_tr_b16 v[112:113], v52 offset:49152
ds_read_b64_tr_b16 v[114:115], v52 offset:49664
ds_read_b64_tr_b16 v[116:117], v52 offset:53248
ds_read_b64_tr_b16 v[118:119], v52 offset:53760
ds_read_b64_tr_b16 v[120:121], v52 offset:57344
ds_read_b64_tr_b16 v[122:123], v52 offset:57856
ds_read_b64_tr_b16 v[124:125], v52 offset:61440
ds_read_b64_tr_b16 v[126:127], v52 offset:61952
L_sh4:
s_branch L_pe3
L_poll1:
buffer_load_dwordx2 v[24:25], v4, s[12:15], s75 offen sc1
buffer_load_dwordx4 v[8:11], v3, s[12:15], s74 offen offset:0 sc1
buffer_load_dwordx4 v[12:15], v3, s[12:15], s74 offen offset:1024 sc1
buffer_load_dwordx4 v[16:19], v3, s[12:15], s74 offen offset:2048 sc1
buffer_load_dwordx4 v[20:23], v3, s[12:15], s74 offen offset:3072 sc1
L_pe3:
s_waitcnt vmcnt(0)
v_max3_u32 v1, v8, v9, v10
v_max3_u32 v1, v1, v11, v12
v_max3_u32 v1, v1, v13, v14
v_max3_u32 v1, v1, v15, v16
v_max3_u32 v1, v1, v17, v18
v_max3_u32 v1, v1, v19, v20
v_max3_u32 v1, v1, v21, v22
v_max3_u32 v1, v1, v23, v24
v_max_u32 v1, v1, v25
v_cmp_eq_u32 vcc, -1, v1
s_sub_u32 s67, s67, 1
s_cbranch_scc1 L_pd2
s_cbranch_vccnz L_poll1
L_pd2:
v_mov_b32 v26, v24
s_nop 1
v_max_f32_dpp v26, v26, v26 row_ror:4 row_mask:0xf bank_mask:0xf
s_nop 1
v_max_f32_dpp v26, v26, v26 row_ror:2 row_mask:0xf bank_mask:0xf
s_nop 1
v_max_f32_dpp v26, v26, v26 row_ror:1 row_mask:0xf bank_mask:0xf
v_sub_f32 v24, v24, v26
v_exp_f32 v24, v24
s_nop 0
v_mul_f32 v25, v24, v25
s_nop 1
v_add_f32_dpp v25, v25, v25 row_ror:4 row_mask:0xf bank_mask:0xf
s_nop 1
v_add_f32_dpp v25, v25, v25 row_ror:2 row_mask:0xf bank_mask:0xf
s_nop 1
v_add_f32_dpp v25, v25, v25 row_ror:1 row_mask:0xf bank_mask:0xf
v_rcp_f32 v25, v25
s_nop 0
v_mul_f32 v24, v24, v25
s_nop 1
v_mul_f32_dpp v28, v24, v8 row_newbcast:0 row_mask:0xf bank_mask:0xf
v_mul_f32_dpp v29, v24, v9 row_newbcast:0 row_mask:0xf bank_mask:0xf
v_mul_f32_dpp v30, v24, v10 row_newbcast:0 row_mask:0xf bank_mask:0xf
v_mul_f32_dpp v31, v24, v11 row_newbcast:0 row_mask:0xf bank_mask:0xf
v_fmac_f32_dpp v28, v24, v12 row_newbcast:2 row_mask:0xf bank_mask:0xf
v_fmac_f32_dpp v29, v24, v13 row_newbcast:2 row_mask:0xf bank_mask:0xf
v_fmac_f32_dpp v30, v24, v14 row_newbcast:2 row_mask:0xf bank_mask:0xf
v_fmac_f32_dpp v31, v24, v15 row_newbcast:2 row_mask:0xf bank_mask:0xf
v_fmac_f32_dpp v28, v24, v16 row_newbcast:4 row_mask:0xf bank_mask:0xf
v_fmac_f32_dpp v29, v24, v17 row_newbcast:4 row_mask:0xf bank_mask:0xf
v_fmac_f32_dpp v30, v24, v18 row_newbcast:4 row_mask:0xf bank_mask:0xf
v_fmac_f32_dpp v31, v24, v19 row_newbcast:4 row_mask:0xf bank_mask:0xf
v_fmac_f32_dpp v28, v24, v20 row_newbcast:6 row_mask:0xf bank_mask:0xf
v_fmac_f32_dpp v29, v24, v21 row_newbcast:6 row_mask:0xf bank_mask:0xf
v_fmac_f32_dpp v30, v24, v22 row_newbcast:6 row_mask:0xf bank_mask:0xf
v_fmac_f32_dpp v31, v24, v23 row_newbcast:6 row_mask:0xf bank_mask:0xf
v_mov_b32 v32, v28
v_mov_b32 v33, v29
v_mov_b32 v34, v30
v_mov_b32 v35, v31
s_nop 0
v_permlane32_swap_b32 v28, v32
v_permlane32_swap_b32 v29, v33
v_permlane32_swap_b32 v30, v34
v_permlane32_swap_b32 v31, v35
v_add_f32 v28, v28, v32
v_add_f32 v29, v29, v33
v_add_f32 v30, v30, v34
v_add_f32 v31, v31, v35
v_cvt_pk_bf16_f32 v28, v28, v29
v_cvt_pk_bf16_f32 v29, v30, v31
s_lshr_b32 s3, s60, 2
s_mul_i32 s3, s3, 1040
s_and_b32 s74, s60, 3
s_lshl_b32 s74, s74, 8
s_add_u32 s3, s3, s74
v_and_b32 v1, 31, v0
v_lshl_add_u32 v1, v1, 3, s3
ds_write_b64 v1, v[28:29] offset:15488
s_waitcnt lgkmcnt(0)
s_barrier
s_cmp_ge_u32 s60, 4
s_cbranch_scc1 L_a1
v_mul_u32_u24 v1, 1040, v57
v_add_u32 v1, v1, v56
ds_read_b128 v[8:11], v1 offset:15488
ds_read_b128 v[12:15], v1 offset:15552
ds_read_b128 v[16:19], v1 offset:15616
ds_read_b128 v[20:23], v1 offset:15680
ds_read_b128 v[24:27], v1 offset:15744
ds_read_b128 v[28:31], v1 offset:15808
ds_read_b128 v[32:35], v1 offset:15872
ds_read_b128 v[36:39], v1 offset:15936
ds_read_b128 v[204:207], v1 offset:16000
ds_read_b128 v[208:211], v1 offset:16064
ds_read_b128 v[212:215], v1 offset:16128
ds_read_b128 v[216:219], v1 offset:16192
ds_read_b128 v[220:223], v1 offset:16256
ds_read_b128 v[224:227], v1 offset:16320
ds_read_b128 v[228:231], v1 offset:16384
ds_read_b128 v[232:235], v1 offset:16448
s_mul_i32 s3, s61, 4608
s_lshl_b32 s74, s70, 8
s_add_u32 s3, s3, s74
s_lshl_b32 s74, s60, 6
s_add_u32 s3, s3, s74
s_add_u32 s3, s3, 524288
v_mul_u32_u24 v2, 2304, v57
v_add_u32 v2, v2, v56
v_lshrrev_b32 v2, 0, v2
s_waitcnt lgkmcnt(15)
v_mfma_f32_16x16x32_bf16 v[40:43], v[64:67], v[8:11], 0
s_waitcnt lgkmcnt(14)
v_mfma_f32_16x16x32_bf16 v[40:43], v[68:71], v[12:15], v[40:43]
s_waitcnt lgkmcnt(13)
v_mfma_f32_16x16x32_bf16 v[40:43], v[72:75], v[16:19], v[40:43]
s_waitcnt lgkmcnt(12)
v_mfma_f32_16x16x32_bf16 v[40:43], v[76:79], v[20:23], v[40:43]
s_waitcnt lgkmcnt(11)
v_mfma_f32_16x16x32_bf16 v[40:43], v[80:83], v[24:27], v[40:43]
s_waitcnt lgkmcnt(10)
v_mfma_f32_16x16x32_bf16 v[40:43], v[84:87], v[28:31], v[40:43]
s_waitcnt lgkmcnt(9)
v_mfma_f32_16x16x32_bf16 v[40:43], v[88:91], v[32:35], v[40:43]
s_waitcnt lgkmcnt(8)
v_mfma_f32_16x16x32_bf16 v[40:43], v[92:95], v[36:39], v[40:43]
s_waitcnt lgkmcnt(7)
v_mfma_f32_16x16x32_bf16 v[40:43], v[96:99], v[204:207], v[40:43]
s_waitcnt lgkmcnt(6)
v_mfma_f32_16x16x32_bf16 v[40:43], v[100:103], v[208:211], v[40:43]
s_waitcnt lgkmcnt(5)
v_mfma_f32_16x16x32_bf16 v[40:43], v[104:107], v[212:215], v[40:43]
s_waitcnt lgkmcnt(4)
v_mfma_f32_16x16x32_bf16 v[40:43], v[108:111], v[216:219], v[40:43]
s_waitcnt lgkmcnt(3)
v_mfma_f32_16x16x32_bf16 v[40:43], v[112:115], v[220:223], v[40:43]
s_waitcnt lgkmcnt(2)
v_mfma_f32_16x16x32_bf16 v[40:43], v[116:119], v[224:227], v[40:43]
s_waitcnt lgkmcnt(1)
v_mfma_f32_16x16x32_bf16 v[40:43], v[120:123], v[228:231], v[40:43]
s_waitcnt lgkmcnt(0)
v_mfma_f32_16x16x32_bf16 v[40:43], v[124:127], v[232:235], v[40:43]
s_nop 7
v_min_u32 v40, -2, v40
v_min_u32 v41, -2, v41
v_min_u32 v42, -2, v42
v_min_u32 v43, -2, v43
s_mov_b32 exec_lo, 0x00030003
s_mov_b32 exec_hi, 0x00030003
buffer_store_dwordx4 v[40:43], v2, s[12:15], s3 offen sc1
s_mov_b64 exec, -1
L_a1:
s_endpgm
L_mlp:
s_mov_b32 s20, s32
s_mov_b32 s21, s33
s_mov_b32 s22, 2304
s_mov_b32 s23, 0x20000
s_barrier
s_cmp_ge_u32 s60, 4
s_cbranch_scc1 L_lt1
s_mov_b32 s16, s44
s_mov_b32 s17, s45
s_mov_b32 s18, 5308416
s_mov_b32 s19, 0x20000
v_lshrrev_b32 v1, 2, v0
v_mul_u32_u24 v1, 9216, v1
v_and_b32 v2, 3, v0
v_lshl_add_u32 v54, v2, 4, v1
v_lshlrev_b32 v55, 4, v0
s_mul_i32 s72, s60, 1327104
s_lshl_b32 s3, s71, 6
s_add_u32 s72, s72, s3
s_mul_i32 s69, s60, 9216
s_add_u32 s69, s69, 23040
s_add_u32 m0, s69, 0
s_add_u32 s68, s72, 0
buffer_load_dwordx4 v54, s[16:19], s68 offen nt lds
s_add_u32 m0, s69, 1024
s_add_u32 s68, s72, 147456
buffer_load_dwordx4 v54, s[16:19], s68 offen nt lds
s_add_u32 m0, s69, 2048
s_add_u32 s68, s72, 294912
buffer_load_dwordx4 v54, s[16:19], s68 offen nt lds
s_add_u32 m0, s69, 3072
s_add_u32 s68, s72, 442368
buffer_load_dwordx4 v54, s[16:19], s68 offen nt lds
s_add_u32 m0, s69, 4096
s_add_u32 s68, s72, 589824
buffer_load_dwordx4 v54, s[16:19], s68 offen nt lds
s_add_u32 m0, s69, 5120
s_add_u32 s68, s72, 737280
buffer_load_dwordx4 v54, s[16:19], s68 offen nt lds
s_add_u32 m0, s69, 6144
s_add_u32 s68, s72, 884736
buffer_load_dwordx4 v54, s[16:19], s68 offen nt lds
s_add_u32 m0, s69, 7168
s_add_u32 s68, s72, 1032192
buffer_load_dwordx4 v54, s[16:19], s68 offen nt lds
s_add_u32 m0, s69, 8192
s_add_u32 s68, s72, 1179648
buffer_load_dwordx4 v54, s[16:19], s68 offen nt lds
s_mov_b32 s16, s48
s_mov_b32 s17, s49
s_mov_b32 s18, 5308416
s_mov_b32 s19, 0x20000
s_mul_i32 s72, s71, 36864
s_mul_i32 s3, s60, 9216
s_add_u32 s72, s72, s3
s_add_u32 s69, s69, 36864
s_add_u32 m0, s69, 0
s_add_u32 s68, s72, 0
buffer_load_dwordx4 v55, s[16:19], s68 offen nt lds
s_add_u32 m0, s69, 1024
s_add_u32 s68, s72, 1024
buffer_load_dwordx4 v55, s[16:19], s68 offen nt lds
s_add_u32 m0, s69, 2048
s_add_u32 s68, s72, 2048
buffer_load_dwordx4 v55, s[16:19], s68 offen nt lds
s_add_u32 m0, s69, 3072
s_add_u32 s68, s72, 3072
buffer_load_dwordx4 v55, s[16:19], s68 offen nt lds
s_add_u32 m0, s69, 4096
s_add_u32 s68, s72, 4096
buffer_load_dwordx4 v55, s[16:19], s68 offen nt lds
s_add_u32 m0, s69, 5120
s_add_u32 s68, s72, 5120
buffer_load_dwordx4 v55, s[16:19], s68 offen nt lds
s_add_u32 m0, s69, 6144
s_add_u32 s68, s72, 6144
buffer_load_dwordx4 v55, s[16:19], s68 offen nt lds
s_add_u32 m0, s69, 7168
s_add_u32 s68, s72, 7168
buffer_load_dwordx4 v55, s[16:19], s68 offen nt lds
s_add_u32 m0, s69, 8192
s_add_u32 s68, s72, 8192
buffer_load_dwordx4 v55, s[16:19], s68 offen nt lds
s_waitcnt vmcnt(0)
L_lt1:
s_barrier
s_lshr_b32 s3, s60, 2
s_mul_i32 s3, s3, 576
s_and_b32 s74, s60, 3
s_mul_i32 s74, s74, 144
s_add_u32 s3, s3, s74
v_min_u32 v1, 35, v0
v_lshl_add_u32 v1, v1, 2, s3
v_lshlrev_b32 v3, 2, v1
v_lshlrev_b32 v4, 1, v1
buffer_load_dwordx2 v[44:45], v4, s[20:23], 0 offen
s_mov_b32 s67, 0x40000
s_mov_b32 s3, 524288
buffer_load_dwordx4 v[8:11], v3, s[12:15], s3 offen sc1
s_mov_b32 s3, 528896
buffer_load_dwordx4 v[12:15], v3, s[12:15], s3 offen sc1
s_mov_b32 s3, 533504
buffer_load_dwordx4 v[16:19], v3, s[12:15], s3 offen sc1
s_mov_b32 s3, 538112
buffer_load_dwordx4 v[20:23], v3, s[12:15], s3 offen sc1
s_mov_b32 s3, 542720
buffer_load_dwordx4 v[24:27], v3, s[12:15], s3 offen sc1
s_mov_b32 s3, 547328
buffer_load_dwordx4 v[28:31], v3, s[12:15], s3 offen sc1
s_mov_b32 s3, 551936
buffer_load_dwordx4 v[32:35], v3, s[12:15], s3 offen sc1
s_mov_b32 s3, 556544
buffer_load_dwordx4 v[36:39], v3, s[12:15], s3 offen sc1
s_cmp_ge_u32 s60, 4
s_cbranch_scc1 L_sh8
ds_read_b64_tr_b16 v[128:129], v52 offset:0
ds_read_b64_tr_b16 v[130:131], v52 offset:256
ds_read_b64_tr_b16 v[132:133], v52 offset:2048
ds_read_b64_tr_b16 v[134:135], v52 offset:2304
ds_read_b64_tr_b16 v[136:137], v52 offset:4096
ds_read_b64_tr_b16 v[138:139], v52 offset:4352
ds_read_b64_tr_b16 v[140:141], v52 offset:6144
ds_read_b64_tr_b16 v[142:143], v52 offset:6400
ds_read_b64_tr_b16 v[144:145], v52 offset:8192
ds_read_b64_tr_b16 v[146:147], v52 offset:8448
ds_read_b64_tr_b16 v[148:149], v52 offset:10240
ds_read_b64_tr_b16 v[150:151], v52 offset:10496
ds_read_b64_tr_b16 v[152:153], v52 offset:12288
ds_read_b64_tr_b16 v[154:155], v52 offset:12544
ds_read_b64_tr_b16 v[156:157], v52 offset:14336
ds_read_b64_tr_b16 v[158:159], v52 offset:14592
ds_read_b64_tr_b16 v[160:161], v52 offset:16384
ds_read_b64_tr_b16 v[162:163], v52 offset:16640
ds_read_b64_tr_b16 v[164:165], v53 offset:0
ds_read_b64_tr_b16 v[166:167], v53 offset:4608
ds_read_b64_tr_b16 v[168:169], v53 offset:32
ds_read_b64_tr_b16 v[170:171], v53 offset:4640
ds_read_b64_tr_b16 v[172:173], v53 offset:64
ds_read_b64_tr_b16 v[174:175], v53 offset:4672
ds_read_b64_tr_b16 v[176:177], v53 offset:96
ds_read_b64_tr_b16 v[178:179], v53 offset:4704
ds_read_b64_tr_b16 v[180:181], v53 offset:128
ds_read_b64_tr_b16 v[182:183], v53 offset:4736
ds_read_b64_tr_b16 v[184:185], v53 offset:160
ds_read_b64_tr_b16 v[186:187], v53 offset:4768
ds_read_b64_tr_b16 v[188:189], v53 offset:192
ds_read_b64_tr_b16 v[190:191], v53 offset:4800
ds_read_b64_tr_b16 v[192:193], v53 offset:224
ds_read_b64_tr_b16 v[194:195], v53 offset:4832
ds_read_b64_tr_b16 v[196:197], v53 offset:256
ds_read_b64_tr_b16 v[198:199], v53 offset:4864
L_sh8:
s_branch L_pe7
L_poll5:
s_mov_b32 s3, 524288
buffer_load_dwordx4 v[8:11], v3, s[12:15], s3 offen sc1
s_mov_b32 s3, 528896
buffer_load_dwordx4 v[12:15], v3, s[12:15], s3 offen sc1
s_mov_b32 s3, 533504
buffer_load_dwordx4 v[16:19], v3, s[12:15], s3 offen sc1
s_mov_b32 s3, 538112
buffer_load_dwordx4 v[20:23], v3, s[12:15], s3 offen sc1
s_mov_b32 s3, 542720
buffer_load_dwordx4 v[24:27], v3, s[12:15], s3 offen sc1
s_mov_b32 s3, 547328
buffer_load_dwordx4 v[28:31], v3, s[12:15], s3 offen sc1
s_mov_b32 s3, 551936
buffer_load_dwordx4 v[32:35], v3, s[12:15], s3 offen sc1
s_mov_b32 s3, 556544
buffer_load_dwordx4 v[36:39], v3, s[12:15], s3 offen sc1
L_pe7:
s_waitcnt vmcnt(0)
v_max3_u32 v1, v8, v9, v10
v_max3_u32 v1, v1, v11, v12
v_max3_u32 v1, v1, v13, v14
v_max3_u32 v1, v1, v15, v16
v_max3_u32 v1, v1, v17, v18
v_max3_u32 v1, v1, v19, v20
v_max3_u32 v1, v1, v21, v22
v_max3_u32 v1, v1, v23, v24
v_max3_u32 v1, v1, v25, v26
v_max3_u32 v1, v1, v27, v28
v_max3_u32 v1, v1, v29, v30
v_max3_u32 v1, v1, v31, v32
v_max3_u32 v1, v1, v33, v34
v_max3_u32 v1, v1, v35, v36
v_max3_u32 v1, v1, v37, v38
v_max_u32 v1, v1, v39
v_cmp_eq_u32 vcc, -1, v1
s_sub_u32 s67, s67, 1
s_cbranch_scc1 L_pd6
s_cbranch_vccnz L_poll5
L_pd6:
v_add_f32 v8, v8, v12
v_add_f32 v9, v9, v13
v_add_f32 v10, v10, v14
v_add_f32 v11, v11, v15
v_add_f32 v16, v16, v20
v_add_f32 v17, v17, v21
v_add_f32 v18, v18, v22
v_add_f32 v19, v19, v23
v_add_f32 v24, v24, v28
v_add_f32 v25, v25, v29
v_add_f32 v26, v26, v30
v_add_f32 v27, v27, v31
v_add_f32 v32, v32, v36
v_add_f32 v33, v33, v37
v_add_f32 v34, v34, v38
v_add_f32 v35, v35, v39
v_add_f32 v8, v8, v16
v_add_f32 v9, v9, v17
v_add_f32 v10, v10, v18
v_add_f32 v11, v11, v19
v_add_f32 v24, v24, v32
v_add_f32 v25, v25, v33
v_add_f32 v26, v26, v34
v_add_f32 v27, v27, v35
v_add_f32 v8, v8, v24
v_add_f32 v9, v9, v25
v_add_f32 v10, v10, v26
v_add_f32 v11, v11, v27
v_cvt_pk_bf16_f32 v8, v8, v9
v_cvt_pk_bf16_f32 v9, v10, v11
v_lshlrev_b32 v12, 16, v8
v_and_b32 v13, 0xffff0000, v8
v_lshlrev_b32 v14, 16, v44
v_and_b32 v15, 0xffff0000, v44
v_add_f32 v12, v12, v14
v_add_f32 v13, v13, v15
v_cvt_pk_bf16_f32 v8, v12, v13
v_lshlrev_b32 v12, 16, v9
v_and_b32 v13, 0xffff0000, v9
v_lshlrev_b32 v14, 16, v45
v_and_b32 v15, 0xffff0000, v45
v_add_f32 v12, v12, v14
v_add_f32 v13, v13, v15
v_cvt_pk_bf16_f32 v9, v12, v13
ds_write_b64 v4, v[8:9] offset:17664
s_waitcnt lgkmcnt(0)
s_barrier
s_cmp_lt_u32 s60, 4
s_cbranch_scc1 L_m1
s_cmp_eq_u32 s60, 4
s_cbranch_scc1 L_st
s_endpgm
L_st:
v_lshrrev_b32 v1, 5, v0
v_mul_u32_u24 v2, 1152, v1
v_and_b32 v3, 31, v0
v_lshl_add_u32 v50, v3, 2, v2
v_lshlrev_b32 v1, 3, v1
ds_read_b32 v40, v50 offset:17664
ds_read_b32 v41, v50 offset:17792
ds_read_b32 v42, v50 offset:17920
ds_read_b32 v43, v50 offset:18048
ds_read_b32 v44, v50 offset:18176
ds_read_b32 v45, v50 offset:18304
ds_read_b32 v46, v50 offset:18432
ds_read_b32 v47, v50 offset:18560
ds_read_b32 v48, v50 offset:18688
s_waitcnt lgkmcnt(0)
v_lshlrev_b32 v8, 16, v40
v_and_b32 v9, 0xffff0000, v40
v_lshlrev_b32 v10, 16, v41
v_and_b32 v11, 0xffff0000, v41
v_lshlrev_b32 v12, 16, v42
v_and_b32 v13, 0xffff0000, v42
v_lshlrev_b32 v14, 16, v43
v_and_b32 v15, 0xffff0000, v43
v_lshlrev_b32 v16, 16, v44
v_and_b32 v17, 0xffff0000, v44
v_lshlrev_b32 v18, 16, v45
v_and_b32 v19, 0xffff0000, v45
v_lshlrev_b32 v20, 16, v46
v_and_b32 v21, 0xffff0000, v46
v_lshlrev_b32 v22, 16, v47
v_and_b32 v23, 0xffff0000, v47
v_lshlrev_b32 v24, 16, v48
v_and_b32 v25, 0xffff0000, v48
v_add_f32 v26, v8, v9
v_add_f32 v26, v26, v10
v_add_f32 v26, v26, v11
v_add_f32 v26, v26, v12
v_add_f32 v26, v26, v13
v_add_f32 v26, v26, v14
v_add_f32 v26, v26, v15
v_add_f32 v26, v26, v16
v_add_f32 v26, v26, v17
v_add_f32 v26, v26, v18
v_add_f32 v26, v26, v19
v_add_f32 v26, v26, v20
v_add_f32 v26, v26, v21
v_add_f32 v26, v26, v22
v_add_f32 v26, v26, v23
v_add_f32 v26, v26, v24
v_add_f32 v26, v26, v25
s_nop 1
v_add_f32_dpp v26, v26, v26 row_ror:8 row_mask:0xf bank_mask:0xf
s_nop 1
v_add_f32_dpp v26, v26, v26 row_ror:4 row_mask:0xf bank_mask:0xf
s_nop 1
v_add_f32_dpp v26, v26, v26 row_ror:2 row_mask:0xf bank_mask:0xf
s_nop 1
v_add_f32_dpp v26, v26, v26 row_ror:1 row_mask:0xf bank_mask:0xf
v_mov_b32 v27, v26
s_nop 1
v_permlane16_swap_b32 v26, v27
v_add_f32 v26, v26, v27
v_mul_f32 v26, 0x3ae38e39, v26
v_mov_b32 v28, v26
v_sub_f32 v8, v8, v26
v_sub_f32 v9, v9, v26
v_sub_f32 v10, v10, v26
v_sub_f32 v11, v11, v26
v_sub_f32 v12, v12, v26
v_sub_f32 v13, v13, v26
v_sub_f32 v14, v14, v26
v_sub_f32 v15, v15, v26
v_sub_f32 v16, v16, v26
v_sub_f32 v17, v17, v26
v_sub_f32 v18, v18, v26
v_sub_f32 v19, v19, v26
v_sub_f32 v20, v20, v26
v_sub_f32 v21, v21, v26
v_sub_f32 v22, v22, v26
v_sub_f32 v23, v23, v26
v_sub_f32 v24, v24, v26
v_sub_f32 v25, v25, v26
v_mul_f32 v26, v8, v8
v_fmac_f32 v26, v9, v9
v_fmac_f32 v26, v10, v10
v_fmac_f32 v26, v11, v11
v_fmac_f32 v26, v12, v12
v_fmac_f32 v26, v13, v13
v_fmac_f32 v26, v14, v14
v_fmac_f32 v26, v15, v15
v_fmac_f32 v26, v16, v16
v_fmac_f32 v26, v17, v17
v_fmac_f32 v26, v18, v18
v_fmac_f32 v26, v19, v19
v_fmac_f32 v26, v20, v20
v_fmac_f32 v26, v21, v21
v_fmac_f32 v26, v22, v22
v_fmac_f32 v26, v23, v23
v_fmac_f32 v26, v24, v24
v_fmac_f32 v26, v25, v25
s_nop 1
v_add_f32_dpp v26, v26, v26 row_ror:8 row_mask:0xf bank_mask:0xf
s_nop 1
v_add_f32_dpp v26, v26, v26 row_ror:4 row_mask:0xf bank_mask:0xf
s_nop 1
v_add_f32_dpp v26, v26, v26 row_ror:2 row_mask:0xf bank_mask:0xf
s_nop 1
v_add_f32_dpp v26, v26, v26 row_ror:1 row_mask:0xf bank_mask:0xf
v_mov_b32 v27, v26
s_nop 1
v_permlane16_swap_b32 v26, v27
v_add_f32 v26, v26, v27
v_mov_b32 v27, 0x3727c5ac
v_fmac_f32 v27, 0x3ae38e39, v26
v_rsq_f32 v27, v27
s_nop 0
v_mov_b32 v29, v27
ds_write_b64 v1, v[28:29] offset:22416
s_waitcnt lgkmcnt(0)
s_barrier
s_endpgm
L_m1:
s_lshr_b32 s3, s60, 1
s_mul_i32 s74, s3, 576
v_mul_u32_u24 v1, 1152, v59
v_add3_u32 v1, v1, v56, s74
ds_read_b128 v[204:207], v1 offset:17664
ds_read_b128 v[208:211], v1 offset:17728
ds_read_b128 v[212:215], v1 offset:17792
ds_read_b128 v[216:219], v1 offset:17856
ds_read_b128 v[220:223], v1 offset:17920
ds_read_b128 v[224:227], v1 offset:17984
ds_read_b128 v[228:231], v1 offset:18048
ds_read_b128 v[232:235], v1 offset:18112
ds_read_b128 v[236:239], v1 offset:18176
s_mul_i32 s3, s3, 384
s_and_b32 s74, s60, 1
s_lshl_b32 s74, s74, 6
s_add_u32 s3, s3, s74
v_lshl_add_u32 v2, v59, 7, v56
v_add_u32 v2, s3, v2
s_waitcnt lgkmcnt(8)
v_mfma_f32_16x16x32_bf16 v[40:43], v[128:131], v[204:207], 0
s_waitcnt lgkmcnt(7)
v_mfma_f32_16x16x32_bf16 v[40:43], v[132:135], v[208:211], v[40:43]
s_waitcnt lgkmcnt(6)
v_mfma_f32_16x16x32_bf16 v[40:43], v[136:139], v[212:215], v[40:43]
s_waitcnt lgkmcnt(5)
v_mfma_f32_16x16x32_bf16 v[40:43], v[140:143], v[216:219], v[40:43]
s_waitcnt lgkmcnt(4)
v_mfma_f32_16x16x32_bf16 v[40:43], v[144:147], v[220:223], v[40:43]
s_waitcnt lgkmcnt(3)
v_mfma_f32_16x16x32_bf16 v[40:43], v[148:151], v[224:227], v[40:43]
s_waitcnt lgkmcnt(2)
v_mfma_f32_16x16x32_bf16 v[40:43], v[152:155], v[228:231], v[40:43]
s_waitcnt lgkmcnt(1)
v_mfma_f32_16x16x32_bf16 v[40:43], v[156:159], v[232:235], v[40:43]
s_waitcnt lgkmcnt(0)
v_mfma_f32_16x16x32_bf16 v[40:43], v[160:163], v[236:239], v[40:43]
v_lshlrev_b32 v1, 2, v0
v_and_b32 v3, 31, v0
v_lshlrev_b32 v3, 2, v3
v_lshrrev_b32 v4, 5, v0
v_lshlrev_b32 v4, 3, v4
s_nop 2
ds_write_b128 v2, v[40:43] offset:21120
s_waitcnt lgkmcnt(0)
s_barrier
ds_read_b32 v8, v1 offset:21120
ds_read_b32 v9, v1 offset:21504
ds_read_b32 v10, v3 offset:21376
ds_read_b32 v11, v3 offset:21760
ds_read_b64 v[12:13], v4 offset:22416
s_lshl_b32 s3, s60, 7
v_lshl_add_u32 v2, v0, 1, s3
v_lshl_add_u32 v3, v57, 6, v56
v_add_u32 v3, s3, v3
s_waitcnt lgkmcnt(0)
v_add_f32 v8, v8, v9
v_add_f32 v10, v10, v11
v_fma_f32 v8, -v12, v10, v8
v_mul_f32 v8, v8, v13
v_cvt_pk_bf16_f32 v8, v8, v8
v_lshlrev_b32 v8, 16, v8
v_add_f32 v8, v8, v200
v_cvt_pk_bf16_f32 v8, v8, v8
v_lshlrev_b32 v8, 16, v8
v_mul_f32 v9, v8, v8
v_mov_b32 v10, 1.0
v_fmac_f32 v10, 0x3d372713, v9
v_mul_f32 v10, v10, v8
v_mul_f32 v10, 0xc0135761, v10
v_exp_f32 v10, v10
s_nop 0
v_add_f32 v10, 1.0, v10
v_rcp_f32 v10, v10
s_nop 0
v_mul_f32 v8, v8, v10
v_cvt_pk_bf16_f32 v8, v8, v8
ds_write_b16 v2, v8 offset:21888
s_waitcnt lgkmcnt(0)
ds_read_b128 v[44:47], v3 offset:21888
s_mul_i32 s3, s71, 4608
s_mul_i32 s74, s60, 576
s_add_u32 s3, s3, s74
s_add_u32 s3, s3, 1048576
v_mul_u32_u24 v2, 2304, v57
v_add_u32 v2, v2, v56
s_waitcnt lgkmcnt(0)
v_mfma_f32_16x16x32_bf16 v[8:11], v[164:167], v[44:47], 0
v_mfma_f32_16x16x32_bf16 v[12:15], v[168:171], v[44:47], 0
v_mfma_f32_16x16x32_bf16 v[16:19], v[172:175], v[44:47], 0
v_mfma_f32_16x16x32_bf16 v[20:23], v[176:179], v[44:47], 0
v_mfma_f32_16x16x32_bf16 v[24:27], v[180:183], v[44:47], 0
v_mfma_f32_16x16x32_bf16 v[28:31], v[184:187], v[44:47], 0
v_mfma_f32_16x16x32_bf16 v[32:35], v[188:191], v[44:47], 0
v_mfma_f32_16x16x32_bf16 v[36:39], v[192:195], v[44:47], 0
v_mfma_f32_16x16x32_bf16 v[40:43], v[196:199], v[44:47], 0
s_mov_b32 exec_lo, 0x00030003
s_mov_b32 exec_hi, 0x00030003
v_min_u32 v8, -2, v8
v_min_u32 v9, -2, v9
v_min_u32 v10, -2, v10
v_min_u32 v11, -2, v11
buffer_store_dwordx4 v[8:11], v2, s[12:15], s3 offen offset:0 sc1
v_min_u32 v12, -2, v12
v_min_u32 v13, -2, v13
v_min_u32 v14, -2, v14
v_min_u32 v15, -2, v15
buffer_store_dwordx4 v[12:15], v2, s[12:15], s3 offen offset:64 sc1
v_min_u32 v16, -2, v16
v_min_u32 v17, -2, v17
v_min_u32 v18, -2, v18
v_min_u32 v19, -2, v19
buffer_store_dwordx4 v[16:19], v2, s[12:15], s3 offen offset:128 sc1
v_min_u32 v20, -2, v20
v_min_u32 v21, -2, v21
v_min_u32 v22, -2, v22
v_min_u32 v23, -2, v23
buffer_store_dwordx4 v[20:23], v2, s[12:15], s3 offen offset:192 sc1
v_min_u32 v24, -2, v24
v_min_u32 v25, -2, v25
v_min_u32 v26, -2, v26
v_min_u32 v27, -2, v27
buffer_store_dwordx4 v[24:27], v2, s[12:15], s3 offen offset:256 sc1
v_min_u32 v28, -2, v28
v_min_u32 v29, -2, v29
v_min_u32 v30, -2, v30
v_min_u32 v31, -2, v31
buffer_store_dwordx4 v[28:31], v2, s[12:15], s3 offen offset:320 sc1
v_min_u32 v32, -2, v32
v_min_u32 v33, -2, v33
v_min_u32 v34, -2, v34
v_min_u32 v35, -2, v35
buffer_store_dwordx4 v[32:35], v2, s[12:15], s3 offen offset:384 sc1
s_nop 3
v_min_u32 v36, -2, v36
v_min_u32 v37, -2, v37
v_min_u32 v38, -2, v38
v_min_u32 v39, -2, v39
buffer_store_dwordx4 v[36:39], v2, s[12:15], s3 offen offset:448 sc1
s_nop 3
v_min_u32 v40, -2, v40
v_min_u32 v41, -2, v41
v_min_u32 v42, -2, v42
v_min_u32 v43, -2, v43
buffer_store_dwordx4 v[40:43], v2, s[12:15], s3 offen offset:512 sc1
s_mov_b64 exec, -1
s_cmp_eq_u32 s60, 0
s_cbranch_scc1 L_m2
s_endpgm
L_m2:
v_lshrrev_b32 v1, 1, v0
v_mul_u32_u24 v1, 4608, v1
v_lshl_add_u32 v3, v57, 4, v1
v_cmp_gt_u32 vcc, 32, v0
v_mov_b32 v5, 0x7f000000
s_lshl_b32 s75, s71, 4
v_cndmask_b32 v4, v5, v3, vcc
v_lshl_add_u32 v5, v57, 3, s75
ds_read_b64 v[46:47], v5 offset:17664
s_lshl_b32 s74, s71, 5
s_add_u32 s74, s74, 1048576
s_mov_b32 s67, 0x40000
L_poll9:
s_add_u32 s3, s74, 0
buffer_load_dwordx4 v[48:51], v3, s[12:15], s3 offen sc1
s_add_u32 s3, s74, 147456
buffer_load_dwordx4 v[52:55], v3, s[12:15], s3 offen sc1
s_add_u32 s3, s74, 294912
buffer_load_dwordx4 v[56:59], v3, s[12:15], s3 offen sc1
s_add_u32 s3, s74, 442368
buffer_load_dwordx4 v[60:63], v3, s[12:15], s3 offen sc1
s_add_u32 s3, s74, 589824
buffer_load_dwordx4 v[64:67], v4, s[12:15], s3 offen sc1
s_waitcnt vmcnt(0)
v_max3_u32 v1, v48, v49, v50
v_max3_u32 v1, v1, v51, v52
v_max3_u32 v1, v1, v53, v54
v_max3_u32 v1, v1, v55, v56
v_max3_u32 v1, v1, v57, v58
v_max3_u32 v1, v1, v59, v60
v_max3_u32 v1, v1, v61, v62
v_max3_u32 v1, v1, v63, v64
v_max3_u32 v1, v1, v65, v66
v_max_u32 v1, v1, v67
v_cmp_eq_u32 vcc, -1, v1
s_sub_u32 s67, s67, 1
s_cbranch_scc1 L_pd10
s_cbranch_vccnz L_poll9
L_pd10:
v_add_f32 v48, v48, v52
v_add_f32 v49, v49, v53
v_add_f32 v50, v50, v54
v_add_f32 v51, v51, v55
v_add_f32 v56, v56, v60
v_add_f32 v57, v57, v61
v_add_f32 v58, v58, v62
v_add_f32 v59, v59, v63
v_add_f32 v48, v48, v56
v_add_f32 v49, v49, v57
v_add_f32 v50, v50, v58
v_add_f32 v51, v51, v59
v_add_f32 v48, v48, v64
v_add_f32 v49, v49, v65
v_add_f32 v50, v50, v66
v_add_f32 v51, v51, v67
v_add_f32_dpp v48, v48, v48 quad_perm:[2,3,0,1] row_mask:0xf bank_mask:0xf
v_add_f32_dpp v49, v49, v49 quad_perm:[2,3,0,1] row_mask:0xf bank_mask:0xf
v_add_f32_dpp v50, v50, v50 quad_perm:[2,3,0,1] row_mask:0xf bank_mask:0xf
v_add_f32_dpp v51, v51, v51 quad_perm:[2,3,0,1] row_mask:0xf bank_mask:0xf
v_add_f32_dpp v48, v48, v48 row_ror:4 row_mask:0xf bank_mask:0xf
v_add_f32_dpp v49, v49, v49 row_ror:4 row_mask:0xf bank_mask:0xf
v_add_f32_dpp v50, v50, v50 row_ror:4 row_mask:0xf bank_mask:0xf
v_add_f32_dpp v51, v51, v51 row_ror:4 row_mask:0xf bank_mask:0xf
v_add_f32_dpp v48, v48, v48 row_ror:8 row_mask:0xf bank_mask:0xf
v_add_f32_dpp v49, v49, v49 row_ror:8 row_mask:0xf bank_mask:0xf
v_add_f32_dpp v50, v50, v50 row_ror:8 row_mask:0xf bank_mask:0xf
v_add_f32_dpp v51, v51, v51 row_ror:8 row_mask:0xf bank_mask:0xf
v_mov_b32 v52, v48
v_mov_b32 v53, v49
v_mov_b32 v54, v50
v_mov_b32 v55, v51
s_nop 0
v_permlane16_swap_b32 v48, v52
v_permlane16_swap_b32 v49, v53
v_permlane16_swap_b32 v50, v54
v_permlane16_swap_b32 v51, v55
v_add_f32 v48, v48, v52
v_add_f32 v49, v49, v53
v_add_f32 v50, v50, v54
v_add_f32 v51, v51, v55
v_mov_b32 v52, v48
v_mov_b32 v53, v49
v_mov_b32 v54, v50
v_mov_b32 v55, v51
s_nop 0
v_permlane32_swap_b32 v48, v52
v_permlane32_swap_b32 v49, v53
v_permlane32_swap_b32 v50, v54
v_permlane32_swap_b32 v51, v55
v_add_f32 v48, v48, v52
v_add_f32 v49, v49, v53
v_add_f32 v50, v50, v54
v_add_f32 v51, v51, v55
v_cvt_pk_bf16_f32 v8, v48, v49
v_cvt_pk_bf16_f32 v9, v50, v51
s_waitcnt lgkmcnt(0)
v_lshlrev_b32 v12, 16, v8
v_and_b32 v13, 0xffff0000, v8
v_lshlrev_b32 v14, 16, v202
v_and_b32 v15, 0xffff0000, v202
v_add_f32 v12, v12, v14
v_add_f32 v13, v13, v15
v_cvt_pk_bf16_f32 v8, v12, v13
v_lshlrev_b32 v12, 16, v9
v_and_b32 v13, 0xffff0000, v9
v_lshlrev_b32 v14, 16, v203
v_and_b32 v15, 0xffff0000, v203
v_add_f32 v12, v12, v14
v_add_f32 v13, v13, v15
v_cvt_pk_bf16_f32 v9, v12, v13
v_lshlrev_b32 v12, 16, v8
v_and_b32 v13, 0xffff0000, v8
v_lshlrev_b32 v14, 16, v46
v_and_b32 v15, 0xffff0000, v46
v_add_f32 v12, v12, v14
v_add_f32 v13, v13, v15
v_cvt_pk_bf16_f32 v8, v12, v13
v_lshlrev_b32 v12, 16, v9
v_and_b32 v13, 0xffff0000, v9
v_lshlrev_b32 v14, 16, v47
v_and_b32 v15, 0xffff0000, v47
v_add_f32 v12, v12, v14
v_add_f32 v13, v13, v15
v_cvt_pk_bf16_f32 v9, v12, v13
s_mov_b32 s20, s52
s_mov_b32 s21, s53
s_mov_b32 s22, 2304
s_mov_b32 s23, 0x20000
s_mov_b64 exec, 3
buffer_store_dwordx2 v[8:9], v5, s[20:23], 0 offen
s_cmp_lg_u32 s71, 0
s_cbranch_scc1 L_m3
s_mov_b64 exec, 1
v_mov_b32 v1, 0
buffer_store_dword v201, v1, s[12:15], 0 offen
L_m3:
s_endpgm
L_exit:
s_endpgm
.section .rodata,"a"
.p2align 6
.amdhsa_kernel sequential_preLN__gqa_block_cached__dense_activation_gelu__decode_kernel
  .amdhsa_next_free_vgpr 256
  .amdhsa_next_free_sgpr 102
  .amdhsa_accum_offset 256
  .amdhsa_group_segment_fixed_size 0
  .amdhsa_kernarg_size 104
  .amdhsa_user_sgpr_count 2
  .amdhsa_user_sgpr_kernarg_segment_ptr 1
  .amdhsa_system_sgpr_workgroup_id_x 1
.end_amdhsa_kernel
```
